```python
import torch

def _softmax(x, axis=-1):
    return torch.softmax(x, dim=axis)
def _gelu(x):
    return torch.nn.functional.gelu(x, approximate="tanh")
def _silu(x):
    return torch.nn.functional.silu(x)
def _sigmoid(x):
    return torch.sigmoid(x)
def _layernorm(x, axis=-1, eps=1e-5):
    m = x.mean(dim=axis, keepdim=True)
    v = x.var(dim=axis, keepdim=True, unbiased=False)
    return (x - m) / torch.sqrt(v + eps)
def _scatter_add(tgt, idx, src, axis=0):
    return tgt.clone().index_add_(axis, idx, src)
def _segment_sum(src, seg, n):
    out = torch.zeros((n,) + src.shape[1:], dtype=src.dtype)
    return out.index_add_(0, seg, src)
def _pad(x, pw):
    flat = tuple(v for pair in reversed(pw) for v in pair)
    return torch.nn.functional.pad(x, flat)

kernel_name = 'standalone__sliding_block_cached__decode'

def setup_inputs():

    _w = (lambda a: (lambda t: t.to(torch.bfloat16) if t.is_floating_point() else t)(torch.as_tensor(a)))
    B, Sq, D = 2, 1, 640
    Hq, Hkv, Sk, Dh = 32, 32, 16384, 192
    assert Hq % Hkv == 0, (Hq, Hkv)
    return {
        "x": _w((lambda *s: torch.randn(*s, dtype=torch.bfloat16) * 1.6)(B, Sq, D)),
        "k_cache": _w((lambda *s: torch.randn(*s, dtype=torch.bfloat16) * 1.6)(B, Hkv, Sk, Dh)),
        "v_cache": _w((lambda *s: torch.randn(*s, dtype=torch.bfloat16) * 0.05)(B, Hkv, Sk, Dh)),
        "wq": _w((lambda *s: torch.randn(*s, dtype=torch.bfloat16) * 1.6)(D, Hq * Dh) * (D ** -0.5)),
        "wo": _w((lambda *s: torch.randn(*s, dtype=torch.bfloat16) * 0.05)(Hq * Dh, D) * ((Hq * Dh) ** -0.5)),
    }

def reference(x, k_cache, v_cache, wq, wo):
    B, Sq, D = x.shape
    Hq, Dh = 32, 192
    Hkv, Sk = k_cache.shape[1], k_cache.shape[2]
    W = min(4096, max(256, Sk // 4))
    rep = Hq // Hkv
    q = (lambda x, *d: x.permute(*d))((x @ wq).reshape(B, Sq, Hq, Dh), 0, 2, 1, 3)
    k = (lambda x, n, axis: torch.repeat_interleave(x, n, dim=axis))(k_cache[:, :, Sk - W:, :], rep, axis=1)
    v = (lambda x, n, axis: torch.repeat_interleave(x, n, dim=axis))(v_cache[:, :, Sk - W:, :], rep, axis=1)
    scores = torch.einsum("bhqd,bhkd->bhqk", q, k) * (Dh ** -0.5)
    p = _softmax(scores, axis=-1)
    o = torch.einsum("bhqk,bhkd->bhqd", p, v)
    return (lambda x, *d: x.permute(*d))(o, 0, 2, 1, 3).reshape(B, Sq, Hq * Dh) @ wo
```

```asm
; @launch grid=(256,1,1) block=(1024,1,1) lds=33536
.amdgcn_target "amdgcn-amd-amdhsa--gfx950"
.text
.globl standalone__sliding_block_cached__decode_kernel
.p2align 8
.type standalone__sliding_block_cached__decode_kernel,@function
standalone__sliding_block_cached__decode_kernel:
  s_cmp_ge_u32 s2, 256
  s_cbranch_scc1 L_end
  s_load_dwordx16 s[4:19], s[0:1], 0
  v_and_b32 v1, 63, v0
  v_lshrrev_b32 v3, 6, v0
  s_nop 0
  v_readfirstlane_b32 s52, v3
  v_lshlrev_b32 v3, 2, v1
  v_mov_b32 v32, 0
  ds_write_b32 v3, v32 offset:0
  v_lshrrev_b32 v35, 3, v1
  v_and_b32 v37, 7, v1
  v_mul_u32_u24 v2, 384, v35
  v_lshl_add_u32 v2, v37, 4, v2
  v_and_b32 v38, 1, v1
  v_cmp_eq_u32 vcc, 1, v38
  v_mov_b32 v38, 0xffff
  v_mov_b32 v39, 0xffff0000
  v_cndmask_b32 v38, v38, v39, vcc
  v_bfe_u32 v39, v1, 1, 2
  v_cmp_eq_u32 vcc, 0, v39
  s_nop 1
  v_cndmask_b32 v4, 0, v38, vcc
  v_cmp_eq_u32 vcc, 1, v39
  s_nop 1
  v_cndmask_b32 v5, 0, v38, vcc
  v_cmp_eq_u32 vcc, 2, v39
  s_nop 1
  v_cndmask_b32 v6, 0, v38, vcc
  v_cmp_eq_u32 vcc, 3, v39
  s_nop 1
  v_cndmask_b32 v7, 0, v38, vcc
  v_lshrrev_b32 v38, 5, v1
  v_bfe_u32 v39, v1, 3, 1
  v_cmp_eq_u32 s[58:59], v38, v39
  v_mov_b32 v36, 0xff
  s_lshr_b32 s53, s2, 3
  s_and_b32 s54, s2, 7
  s_lshr_b32 s55, s52, 3
  s_and_b32 s56, s52, 7
  s_lshl_b32 s57, s55, 5
  s_add_u32 s57, s57, s53
  s_mul_i32 s57, s57, 6291456
  s_add_u32 s57, s57, 4718592
  s_mov_b32 s51, s57
  s_mul_i32 s60, s54, 147456
  s_add_u32 s57, s57, s60
  s_mul_i32 s60, s56, 18432
  s_add_u32 s57, s57, s60
  s_mov_b32 s60, 6144
  s_mov_b32 s61, 12288
  s_mov_b32 s62, 18432
  s_mov_b32 s22, 18432
  s_mov_b32 s23, 0x00020000
  s_mov_b32 s26, 18432
  s_mov_b32 s27, 0x00020000
  s_mov_b32 s30, 4194304
  s_mov_b32 s31, 0x00020000
  s_mov_b32 s72, 0x0c0c0400
  s_mov_b32 s73, 0x04000c0c
  s_waitcnt lgkmcnt(0)
  s_load_dword s68, s[18:19], 983040
  s_add_u32 s20, s6, s57
  s_addc_u32 s21, s7, 0
  s_and_b32 s21, s21, 0xffff
  s_add_u32 s24, s8, s57
  s_addc_u32 s25, s9, 0
  s_and_b32 s25, s25, 0xffff
  s_mov_b32 s28, s18
  s_and_b32 s29, s19, 0xffff
  s_cmp_ge_u32 s54, 2
  s_cbranch_scc1 L_notq
  s_cmp_ge_u32 s52, 8
  s_cbranch_scc1 L_notq
  s_or_b32 s63, s52, s54
  s_cmp_lg_u32 s63, 0
  s_cbranch_scc1 L_noinit
  s_lshl_b32 s63, s53, 8
  s_add_u32 s63, s63, 917504
  v_lshlrev_b32 v38, 7, v1
  s_mov_b64 exec, 3
  buffer_store_dword v32, v38, s[28:31], s63 offen sc1
  s_mov_b64 exec, -1
L_noinit:
  s_mov_b32 s40, s4
  s_and_b32 s41, s5, 0xffff
  s_mov_b32 s42, 2560
  s_mov_b32 s43, 0x00020000
  s_mul_i32 s63, s54, 320
  s_mul_i32 s66, s52, 40
  s_add_u32 s63, s63, s66
  s_mul_i32 s66, s63, 12288
  s_mul_i32 s67, s53, 384
  s_add_u32 s66, s66, s67
  s_add_u32 s36, s10, s66
  s_addc_u32 s37, s11, 0
  s_and_b32 s37, s37, 0xffff
  s_mov_b32 s38, 479616
  s_mov_b32 s39, 0x00020000
  s_mov_b32 s67, 12288
  v_mul_lo_u32 v38, v35, s67
  v_lshl_add_u32 v38, v37, 4, v38
  s_mov_b32 s67, 0
  buffer_load_dwordx4 v[40:43], v38, s[36:39], s67 offen offset:0 nt
  buffer_load_dwordx4 v[44:47], v38, s[36:39], s67 offen offset:128 nt
  buffer_load_dwordx4 v[48:51], v38, s[36:39], s67 offen offset:256 nt
  s_mov_b32 s67, 98304
  buffer_load_dwordx4 v[52:55], v38, s[36:39], s67 offen offset:0 nt
  buffer_load_dwordx4 v[56:59], v38, s[36:39], s67 offen offset:128 nt
  buffer_load_dwordx4 v[60:63], v38, s[36:39], s67 offen offset:256 nt
  s_mov_b32 s67, 196608
  buffer_load_dwordx4 v[64:67], v38, s[36:39], s67 offen offset:0 nt
  buffer_load_dwordx4 v[68:71], v38, s[36:39], s67 offen offset:128 nt
  buffer_load_dwordx4 v[72:75], v38, s[36:39], s67 offen offset:256 nt
  s_mov_b32 s67, 294912
  buffer_load_dwordx4 v[76:79], v38, s[36:39], s67 offen offset:0 nt
  buffer_load_dwordx4 v[80:83], v38, s[36:39], s67 offen offset:128 nt
  buffer_load_dwordx4 v[84:87], v38, s[36:39], s67 offen offset:256 nt
  s_mov_b32 s67, 393216
  buffer_load_dwordx4 v[88:91], v38, s[36:39], s67 offen offset:0 nt
  buffer_load_dwordx4 v[92:95], v38, s[36:39], s67 offen offset:128 nt
  buffer_load_dwordx4 v[96:99], v38, s[36:39], s67 offen offset:256 nt
  s_lshl_b32 s66, s63, 1
  v_lshlrev_b32 v39, 1, v35
  buffer_load_ushort v20, v39, s[40:43], s66 offen offset:0
  buffer_load_ushort v21, v39, s[40:43], s66 offen offset:16
  buffer_load_ushort v22, v39, s[40:43], s66 offen offset:32
  buffer_load_ushort v23, v39, s[40:43], s66 offen offset:48
  buffer_load_ushort v24, v39, s[40:43], s66 offen offset:64
  buffer_load_ushort v8, v39, s[40:43], s66 offen offset:1280
  buffer_load_ushort v9, v39, s[40:43], s66 offen offset:1296
  buffer_load_ushort v10, v39, s[40:43], s66 offen offset:1312
  buffer_load_ushort v11, v39, s[40:43], s66 offen offset:1328
  buffer_load_ushort v12, v39, s[40:43], s66 offen offset:1344
  s_barrier
  s_waitcnt vmcnt(0)
  v_lshl_or_b32 v20, v20, 16, v20
  v_lshl_or_b32 v21, v21, 16, v21
  v_lshl_or_b32 v22, v22, 16, v22
  v_lshl_or_b32 v23, v23, 16, v23
  v_lshl_or_b32 v24, v24, 16, v24
  v_lshl_or_b32 v8, v8, 16, v8
  v_lshl_or_b32 v9, v9, 16, v9
  v_lshl_or_b32 v10, v10, 16, v10
  v_lshl_or_b32 v11, v11, 16, v11
  v_lshl_or_b32 v12, v12, 16, v12
  v_and_b32 v28, v20, v4
  v_and_b32 v29, v20, v5
  v_and_b32 v30, v20, v6
  v_and_b32 v31, v20, v7
  v_and_b32 v124, v8, v4
  v_and_b32 v125, v8, v5
  v_and_b32 v126, v8, v6
  v_and_b32 v127, v8, v7
  v_mfma_f32_16x16x32_bf16 v[100:103], v[40:43], v[28:31], 0
  v_mfma_f32_16x16x32_bf16 v[104:107], v[44:47], v[28:31], 0
  v_mfma_f32_16x16x32_bf16 v[108:111], v[48:51], v[28:31], 0
  v_mfma_f32_16x16x32_bf16 v[112:115], v[40:43], v[124:127], 0
  v_mfma_f32_16x16x32_bf16 v[116:119], v[44:47], v[124:127], 0
  v_mfma_f32_16x16x32_bf16 v[120:123], v[48:51], v[124:127], 0
  v_and_b32 v28, v21, v4
  v_and_b32 v29, v21, v5
  v_and_b32 v30, v21, v6
  v_and_b32 v31, v21, v7
  v_and_b32 v124, v9, v4
  v_and_b32 v125, v9, v5
  v_and_b32 v126, v9, v6
  v_and_b32 v127, v9, v7
  v_mfma_f32_16x16x32_bf16 v[100:103], v[52:55], v[28:31], v[100:103]
  v_mfma_f32_16x16x32_bf16 v[104:107], v[56:59], v[28:31], v[104:107]
  v_mfma_f32_16x16x32_bf16 v[108:111], v[60:63], v[28:31], v[108:111]
  v_mfma_f32_16x16x32_bf16 v[112:115], v[52:55], v[124:127], v[112:115]
  v_mfma_f32_16x16x32_bf16 v[116:119], v[56:59], v[124:127], v[116:119]
  v_mfma_f32_16x16x32_bf16 v[120:123], v[60:63], v[124:127], v[120:123]
  v_and_b32 v28, v22, v4
  v_and_b32 v29, v22, v5
  v_and_b32 v30, v22, v6
  v_and_b32 v31, v22, v7
  v_and_b32 v124, v10, v4
  v_and_b32 v125, v10, v5
  v_and_b32 v126, v10, v6
  v_and_b32 v127, v10, v7
  v_mfma_f32_16x16x32_bf16 v[100:103], v[64:67], v[28:31], v[100:103]
  v_mfma_f32_16x16x32_bf16 v[104:107], v[68:71], v[28:31], v[104:107]
  v_mfma_f32_16x16x32_bf16 v[108:111], v[72:75], v[28:31], v[108:111]
  v_mfma_f32_16x16x32_bf16 v[112:115], v[64:67], v[124:127], v[112:115]
  v_mfma_f32_16x16x32_bf16 v[116:119], v[68:71], v[124:127], v[116:119]
  v_mfma_f32_16x16x32_bf16 v[120:123], v[72:75], v[124:127], v[120:123]
  v_and_b32 v28, v23, v4
  v_and_b32 v29, v23, v5
  v_and_b32 v30, v23, v6
  v_and_b32 v31, v23, v7
  v_and_b32 v124, v11, v4
  v_and_b32 v125, v11, v5
  v_and_b32 v126, v11, v6
  v_and_b32 v127, v11, v7
  v_mfma_f32_16x16x32_bf16 v[100:103], v[76:79], v[28:31], v[100:103]
  v_mfma_f32_16x16x32_bf16 v[104:107], v[80:83], v[28:31], v[104:107]
  v_mfma_f32_16x16x32_bf16 v[108:111], v[84:87], v[28:31], v[108:111]
  v_mfma_f32_16x16x32_bf16 v[112:115], v[76:79], v[124:127], v[112:115]
  v_mfma_f32_16x16x32_bf16 v[116:119], v[80:83], v[124:127], v[116:119]
  v_mfma_f32_16x16x32_bf16 v[120:123], v[84:87], v[124:127], v[120:123]
  v_and_b32 v28, v24, v4
  v_and_b32 v29, v24, v5
  v_and_b32 v30, v24, v6
  v_and_b32 v31, v24, v7
  v_and_b32 v124, v12, v4
  v_and_b32 v125, v12, v5
  v_and_b32 v126, v12, v6
  v_and_b32 v127, v12, v7
  v_mfma_f32_16x16x32_bf16 v[100:103], v[88:91], v[28:31], v[100:103]
  v_mfma_f32_16x16x32_bf16 v[104:107], v[92:95], v[28:31], v[104:107]
  v_mfma_f32_16x16x32_bf16 v[108:111], v[96:99], v[28:31], v[108:111]
  v_mfma_f32_16x16x32_bf16 v[112:115], v[88:91], v[124:127], v[112:115]
  v_mfma_f32_16x16x32_bf16 v[116:119], v[92:95], v[124:127], v[116:119]
  v_mfma_f32_16x16x32_bf16 v[120:123], v[96:99], v[124:127], v[120:123]
  v_lshrrev_b32 v38, 5, v1
  v_mul_u32_u24 v38, 1536, v38
  v_bfe_u32 v39, v1, 4, 1
  v_lshl_add_u32 v38, v39, 7, v38
  v_lshl_add_u32 v38, v37, 2, v38
  s_mul_i32 s66, s52, 3072
  s_add_u32 s66, s66, 8704
  v_add_u32 v38, s66, v38
  v_add_u32 v39, 768, v38
  s_mov_b64 exec, s[58:59]
  ds_write2_b32 v38, v100, v101 offset0:0 offset1:8
  ds_write2_b32 v38, v102, v103 offset0:16 offset1:24
  ds_write2_b32 v38, v104, v105 offset0:64 offset1:72
  ds_write2_b32 v38, v106, v107 offset0:80 offset1:88
  ds_write2_b32 v38, v108, v109 offset0:128 offset1:136
  ds_write2_b32 v38, v110, v111 offset0:144 offset1:152
  ds_write2_b32 v39, v112, v113 offset0:0 offset1:8
  ds_write2_b32 v39, v114, v115 offset0:16 offset1:24
  ds_write2_b32 v39, v116, v117 offset0:64 offset1:72
  ds_write2_b32 v39, v118, v119 offset0:80 offset1:88
  ds_write2_b32 v39, v120, v121 offset0:128 offset1:136
  ds_write2_b32 v39, v122, v123 offset0:144 offset1:152
  s_mov_b64 exec, 1
  v_mov_b32 v3, 1
  ds_add_u32 v32, v3 offset:0
  s_mov_b64 exec, -1
  s_cmp_ge_u32 s52, 2
  s_cbranch_scc1 L_main
  s_waitcnt lgkmcnt(0)
  s_add_u32 s33, s68, 1
  s_mul_i32 s68, s33, 0x9e3779b1
  s_lshr_b32 s69, s68, 8
  s_lshr_b32 s70, s68, 16
  s_lshr_b32 s71, s68, 24
  v_mul_u32_u24 v38, 12, v1
  s_mul_i32 s66, s52, 768
  v_add_u32 v38, s66, v38
  v_add_u32 v39, 4, v38
  v_add_u32 v3, 8, v38
  v_mov_b32 v33, v3
  s_mov_b32 s64, 0
L_spl_1:
  ds_read_b32 v3, v32 offset:0
  s_waitcnt lgkmcnt(0)
  v_readfirstlane_b32 s65, v3
  s_nop 1
  s_cmp_ge_u32 s65, 8
  s_cbranch_scc1 L_spld_2
  s_add_u32 s64, s64, 1
  s_cmp_lt_u32 s64, 2097152
  s_sleep 0
  s_cbranch_scc1 L_spl_1
L_spld_2:
  ds_read2st64_b32 v[40:41], v38 offset0:34 offset1:40
  ds_read2st64_b32 v[42:43], v38 offset0:46 offset1:52
  ds_read2st64_b32 v[44:45], v38 offset0:58 offset1:64
  ds_read2st64_b32 v[46:47], v38 offset0:70 offset1:76
  ds_read2st64_b32 v[48:49], v38 offset0:82 offset1:88
  ds_read2st64_b32 v[50:51], v38 offset0:94 offset1:100
  ds_read2st64_b32 v[52:53], v38 offset0:106 offset1:112
  ds_read2st64_b32 v[54:55], v38 offset0:118 offset1:124
  ds_read2st64_b32 v[56:57], v39 offset0:34 offset1:40
  ds_read2st64_b32 v[58:59], v39 offset0:46 offset1:52
  ds_read2st64_b32 v[60:61], v39 offset0:58 offset1:64
  ds_read2st64_b32 v[62:63], v39 offset0:70 offset1:76
  ds_read2st64_b32 v[64:65], v39 offset0:82 offset1:88
  ds_read2st64_b32 v[66:67], v39 offset0:94 offset1:100
  ds_read2st64_b32 v[68:69], v39 offset0:106 offset1:112
  ds_read2st64_b32 v[70:71], v39 offset0:118 offset1:124
  ds_read2st64_b32 v[72:73], v33 offset0:34 offset1:40
  ds_read2st64_b32 v[74:75], v33 offset0:46 offset1:52
  ds_read2st64_b32 v[76:77], v33 offset0:58 offset1:64
  ds_read2st64_b32 v[78:79], v33 offset0:70 offset1:76
  ds_read2st64_b32 v[80:81], v33 offset0:82 offset1:88
  ds_read2st64_b32 v[82:83], v33 offset0:94 offset1:100
  ds_read2st64_b32 v[84:85], v33 offset0:106 offset1:112
  ds_read2st64_b32 v[86:87], v33 offset0:118 offset1:124
  s_mul_i32 s66, s53, 2
  s_add_u32 s66, s66, s54
  s_lshl_b32 s66, s66, 11
  s_lshl_b32 s67, s52, 10
  s_add_u32 s66, s66, s67
  s_waitcnt lgkmcnt(0)
  v_add_f32 v40, v40, v41
  v_add_f32 v42, v42, v43
  v_add_f32 v44, v44, v45
  v_add_f32 v46, v46, v47
  v_add_f32 v48, v48, v49
  v_add_f32 v50, v50, v51
  v_add_f32 v52, v52, v53
  v_add_f32 v54, v54, v55
  v_add_f32 v56, v56, v57
  v_add_f32 v58, v58, v59
  v_add_f32 v60, v60, v61
  v_add_f32 v62, v62, v63
  v_add_f32 v64, v64, v65
  v_add_f32 v66, v66, v67
  v_add_f32 v68, v68, v69
  v_add_f32 v70, v70, v71
  v_add_f32 v72, v72, v73
  v_add_f32 v74, v74, v75
  v_add_f32 v76, v76, v77
  v_add_f32 v78, v78, v79
  v_add_f32 v80, v80, v81
  v_add_f32 v82, v82, v83
  v_add_f32 v84, v84, v85
  v_add_f32 v86, v86, v87
  v_add_f32 v40, v40, v42
  v_add_f32 v44, v44, v46
  v_add_f32 v48, v48, v50
  v_add_f32 v52, v52, v54
  v_add_f32 v56, v56, v58
  v_add_f32 v60, v60, v62
  v_add_f32 v64, v64, v66
  v_add_f32 v68, v68, v70
  v_add_f32 v72, v72, v74
  v_add_f32 v76, v76, v78
  v_add_f32 v80, v80, v82
  v_add_f32 v84, v84, v86
  v_add_f32 v40, v40, v44
  v_add_f32 v48, v48, v52
  v_add_f32 v56, v56, v60
  v_add_f32 v64, v64, v68
  v_add_f32 v72, v72, v76
  v_add_f32 v80, v80, v84
  v_add_f32 v40, v40, v48
  v_add_f32 v56, v56, v64
  v_add_f32 v72, v72, v80
  v_mov_b32 v100, v40
  v_mov_b32 v101, v56
  v_mov_b32 v102, v72
  v_mov_b32 v103, s68
  v_lshlrev_b32 v39, 4, v1
  buffer_store_dwordx4 v[100:103], v39, s[28:31], s66 offen offset:0 sc1
L_qgather:
  v_lshlrev_b32 v38, 4, v1
  s_mul_i32 s63, s53, 4096
  s_lshl_b32 s67, s52, 10
  s_add_u32 s63, s63, s67
  s_mov_b32 s64, 0
L_qpoll:
  s_mov_b32 s66, s63
  buffer_load_dwordx4 v[40:43], v38, s[28:31], s66 offen offset:0 sc1
  s_add_u32 s66, s66, 2048
  buffer_load_dwordx4 v[44:47], v38, s[28:31], s66 offen offset:0 sc1
  s_waitcnt vmcnt(0)
  v_xor_b32 v72, s68, v43
  v_xor_b32 v73, s68, v47
  v_or_b32 v72, v72, v73
  v_cmp_ne_u32 vcc, 0, v72
  s_nop 1
  s_cbranch_vccz L_qpolld
  s_add_u32 s64, s64, 1
  s_cmp_lt_u32 s64, 65536
  s_cbranch_scc1 L_qpoll
L_qpolld:
  v_mul_u32_u24 v39, 6, v1
  s_mul_i32 s67, s52, 384
  v_add_u32 v39, s67, v39
  v_add_f32 v40, v40, v44
  v_add_f32 v41, v41, v45
  v_add_f32 v42, v42, v46
  v_cvt_pk_bf16_f32 v44, v40, v41
  v_cvt_pk_bf16_f32 v45, v42, v42
  ds_write_b16 v39, v44 offset:256
  ds_write_b16_d16_hi v39, v44 offset:258
  ds_write_b16 v39, v45 offset:260
  s_mov_b64 exec, 1
  s_lshl_b32 s67, s52, 2
  v_mov_b32 v39, s67
  v_mov_b32 v3, 1
  s_waitcnt lgkmcnt(0)
  ds_write_b32 v39, v3 offset:4
  s_mov_b64 exec, -1
  s_branch L_main
L_notq:
  s_barrier
  s_cmp_ge_u32 s52, 2
  s_cbranch_scc1 L_main
  s_waitcnt lgkmcnt(0)
  s_add_u32 s33, s68, 1
  s_mul_i32 s68, s33, 0x9e3779b1
  s_lshr_b32 s69, s68, 8
  s_lshr_b32 s70, s68, 16
  s_lshr_b32 s71, s68, 24
  s_branch L_qgather
L_main:
  buffer_load_dwordx4 v[40:43], v2, s[20:23], 0 offen offset:0 nt
  buffer_load_dwordx4 v[44:47], v2, s[20:23], 0 offen offset:128 nt
  buffer_load_dwordx4 v[48:51], v2, s[20:23], 0 offen offset:256 nt
  buffer_load_dwordx4 v[52:55], v2, s[20:23], 0 offen offset:3072 nt
  buffer_load_dwordx4 v[56:59], v2, s[20:23], 0 offen offset:3200 nt
  buffer_load_dwordx4 v[60:63], v2, s[20:23], 0 offen offset:3328 nt
  s_waitcnt vmcnt(3)
  buffer_load_dwordx4 v[64:67], v2, s[20:23], s60 offen offset:0 nt
  buffer_load_dwordx4 v[68:71], v2, s[20:23], s60 offen offset:128 nt
  buffer_load_dwordx4 v[72:75], v2, s[20:23], s60 offen offset:256 nt
  s_waitcnt vmcnt(3)
  buffer_load_dwordx4 v[76:79], v2, s[20:23], s60 offen offset:3072 nt
  buffer_load_dwordx4 v[80:83], v2, s[20:23], s60 offen offset:3200 nt
  buffer_load_dwordx4 v[84:87], v2, s[20:23], s60 offen offset:3328 nt
  s_waitcnt vmcnt(3)
  buffer_load_dwordx4 v[88:91], v2, s[20:23], s61 offen offset:0 nt
  buffer_load_dwordx4 v[92:95], v2, s[20:23], s61 offen offset:128 nt
  buffer_load_dwordx4 v[96:99], v2, s[20:23], s61 offen offset:256 nt
  s_waitcnt vmcnt(3)
  buffer_load_dwordx4 v[100:103], v2, s[20:23], s61 offen offset:3072 nt
  buffer_load_dwordx4 v[104:107], v2, s[20:23], s61 offen offset:3200 nt
  buffer_load_dwordx4 v[108:111], v2, s[20:23], s61 offen offset:3328 nt
  s_waitcnt vmcnt(3)
  buffer_load_dwordx4 v[112:115], v2, s[24:27], 0 offen offset:0 nt
  buffer_load_dwordx4 v[116:119], v2, s[24:27], 0 offen offset:128 nt
  buffer_load_dwordx4 v[120:123], v2, s[24:27], 0 offen offset:256 nt
  s_lshl_b32 s66, s55, 2
  v_mov_b32 v39, s66
  s_mov_b32 s64, 0
L_spl_3:
  ds_read_b32 v3, v39 offset:4
  s_waitcnt lgkmcnt(0)
  v_readfirstlane_b32 s65, v3
  s_nop 1
  s_cmp_ge_u32 s65, 1
  s_cbranch_scc1 L_spld_4
  s_add_u32 s64, s64, 1
  s_cmp_lt_u32 s64, 2097152
  s_sleep 1
  s_cbranch_scc1 L_spl_3
L_spld_4:
  s_cmp_lt_u32 s52, 2
  s_cbranch_scc1 L_havetag
  s_add_u32 s33, s68, 1
  s_mul_i32 s68, s33, 0x9e3779b1
  s_lshr_b32 s69, s68, 8
  s_lshr_b32 s70, s68, 16
  s_lshr_b32 s71, s68, 24
L_havetag:
  s_mul_i32 s66, s55, 384
  v_lshlrev_b32 v38, 4, v37
  v_add_u32 v38, s66, v38
  ds_read_b128 v[8:11], v38 offset:256
  ds_read_b128 v[12:15], v38 offset:384
  ds_read_b128 v[16:19], v38 offset:512
  s_waitcnt lgkmcnt(0)
  s_waitcnt vmcnt(15)
  v_dot2_f32_bf16 v20, v40, v8, 0
  v_dot2_f32_bf16 v21, v52, v8, 0
  v_dot2_f32_bf16 v20, v41, v9, v20
  v_dot2_f32_bf16 v21, v53, v9, v21
  v_dot2_f32_bf16 v20, v42, v10, v20
  v_dot2_f32_bf16 v21, v54, v10, v21
  v_dot2_f32_bf16 v20, v43, v11, v20
  v_dot2_f32_bf16 v21, v55, v11, v21
  v_dot2_f32_bf16 v20, v44, v12, v20
  v_dot2_f32_bf16 v21, v56, v12, v21
  v_dot2_f32_bf16 v20, v45, v13, v20
  v_dot2_f32_bf16 v21, v57, v13, v21
  v_dot2_f32_bf16 v20, v46, v14, v20
  v_dot2_f32_bf16 v21, v58, v14, v21
  v_dot2_f32_bf16 v20, v47, v15, v20
  v_dot2_f32_bf16 v21, v59, v15, v21
  v_dot2_f32_bf16 v20, v48, v16, v20
  v_dot2_f32_bf16 v21, v60, v16, v21
  v_dot2_f32_bf16 v20, v49, v17, v20
  v_dot2_f32_bf16 v21, v61, v17, v21
  v_dot2_f32_bf16 v20, v50, v18, v20
  v_dot2_f32_bf16 v21, v62, v18, v21
  v_dot2_f32_bf16 v20, v51, v19, v20
  v_dot2_f32_bf16 v21, v63, v19, v21
  buffer_load_dwordx4 v[40:43], v2, s[24:27], 0 offen offset:3072 nt
  buffer_load_dwordx4 v[44:47], v2, s[24:27], 0 offen offset:3200 nt
  buffer_load_dwordx4 v[48:51], v2, s[24:27], 0 offen offset:3328 nt
  buffer_load_dwordx4 v[52:55], v2, s[24:27], s60 offen offset:0 nt
  buffer_load_dwordx4 v[56:59], v2, s[24:27], s60 offen offset:128 nt
  buffer_load_dwordx4 v[60:63], v2, s[24:27], s60 offen offset:256 nt
  v_add_f32_dpp v20, v20, v20 quad_perm:[1,0,3,2] row_mask:0xf bank_mask:0xf
  v_add_f32_dpp v21, v21, v21 quad_perm:[1,0,3,2] row_mask:0xf bank_mask:0xf
  s_nop 0
  v_add_f32_dpp v20, v20, v20 quad_perm:[2,3,0,1] row_mask:0xf bank_mask:0xf
  v_add_f32_dpp v21, v21, v21 quad_perm:[2,3,0,1] row_mask:0xf bank_mask:0xf
  s_nop 0
  v_add_f32_dpp v20, v20, v20 row_half_mirror row_mask:0xf bank_mask:0xf
  v_add_f32_dpp v21, v21, v21 row_half_mirror row_mask:0xf bank_mask:0xf
  v_cvt_pk_bf16_f32 v32, v20, v20
  v_cvt_pk_bf16_f32 v33, v21, v21
  v_and_b32 v32, 0xffff0000, v32
  v_and_b32 v33, 0xffff0000, v33
  v_mul_f32 v32, 0x3d93cd3a, v32
  v_mul_f32 v33, 0x3d93cd3a, v33
  v_cvt_pk_bf16_f32 v32, v32, v32
  v_cvt_pk_bf16_f32 v33, v33, v33
  v_and_b32 v32, 0xffff0000, v32
  v_and_b32 v33, 0xffff0000, v33
  v_mul_f32 v20, 0x3fb8aa3b, v32
  v_mul_f32 v21, 0x3fb8aa3b, v33
  s_waitcnt vmcnt(15)
  v_dot2_f32_bf16 v22, v64, v8, 0
  v_dot2_f32_bf16 v23, v76, v8, 0
  v_dot2_f32_bf16 v22, v65, v9, v22
  v_dot2_f32_bf16 v23, v77, v9, v23
  v_dot2_f32_bf16 v22, v66, v10, v22
  v_dot2_f32_bf16 v23, v78, v10, v23
  v_dot2_f32_bf16 v22, v67, v11, v22
  v_dot2_f32_bf16 v23, v79, v11, v23
  v_dot2_f32_bf16 v22, v68, v12, v22
  v_dot2_f32_bf16 v23, v80, v12, v23
  v_dot2_f32_bf16 v22, v69, v13, v22
  v_dot2_f32_bf16 v23, v81, v13, v23
  v_dot2_f32_bf16 v22, v70, v14, v22
  v_dot2_f32_bf16 v23, v82, v14, v23
  v_dot2_f32_bf16 v22, v71, v15, v22
  v_dot2_f32_bf16 v23, v83, v15, v23
  v_dot2_f32_bf16 v22, v72, v16, v22
  v_dot2_f32_bf16 v23, v84, v16, v23
  v_dot2_f32_bf16 v22, v73, v17, v22
  v_dot2_f32_bf16 v23, v85, v17, v23
  v_dot2_f32_bf16 v22, v74, v18, v22
  v_dot2_f32_bf16 v23, v86, v18, v23
  v_dot2_f32_bf16 v22, v75, v19, v22
  v_dot2_f32_bf16 v23, v87, v19, v23
  buffer_load_dwordx4 v[64:67], v2, s[24:27], s60 offen offset:3072 nt
  buffer_load_dwordx4 v[68:71], v2, s[24:27], s60 offen offset:3200 nt
  buffer_load_dwordx4 v[72:75], v2, s[24:27], s60 offen offset:3328 nt
  buffer_load_dwordx4 v[76:79], v2, s[24:27], s61 offen offset:0 nt
  buffer_load_dwordx4 v[80:83], v2, s[24:27], s61 offen offset:128 nt
  buffer_load_dwordx4 v[84:87], v2, s[24:27], s61 offen offset:256 nt
  v_add_f32_dpp v22, v22, v22 quad_perm:[1,0,3,2] row_mask:0xf bank_mask:0xf
  v_add_f32_dpp v23, v23, v23 quad_perm:[1,0,3,2] row_mask:0xf bank_mask:0xf
  s_nop 0
  v_add_f32_dpp v22, v22, v22 quad_perm:[2,3,0,1] row_mask:0xf bank_mask:0xf
  v_add_f32_dpp v23, v23, v23 quad_perm:[2,3,0,1] row_mask:0xf bank_mask:0xf
  s_nop 0
  v_add_f32_dpp v22, v22, v22 row_half_mirror row_mask:0xf bank_mask:0xf
  v_add_f32_dpp v23, v23, v23 row_half_mirror row_mask:0xf bank_mask:0xf
  v_cvt_pk_bf16_f32 v32, v22, v22
  v_cvt_pk_bf16_f32 v33, v23, v23
  v_and_b32 v32, 0xffff0000, v32
  v_and_b32 v33, 0xffff0000, v33
  v_mul_f32 v32, 0x3d93cd3a, v32
  v_mul_f32 v33, 0x3d93cd3a, v33
  v_cvt_pk_bf16_f32 v32, v32, v32
  v_cvt_pk_bf16_f32 v33, v33, v33
  v_and_b32 v32, 0xffff0000, v32
  v_and_b32 v33, 0xffff0000, v33
  v_mul_f32 v22, 0x3fb8aa3b, v32
  v_mul_f32 v23, 0x3fb8aa3b, v33
  s_waitcnt vmcnt(15)
  v_dot2_f32_bf16 v24, v88, v8, 0
  v_dot2_f32_bf16 v25, v100, v8, 0
  v_dot2_f32_bf16 v24, v89, v9, v24
  v_dot2_f32_bf16 v25, v101, v9, v25
  v_dot2_f32_bf16 v24, v90, v10, v24
  v_dot2_f32_bf16 v25, v102, v10, v25
  v_dot2_f32_bf16 v24, v91, v11, v24
  v_dot2_f32_bf16 v25, v103, v11, v25
  v_dot2_f32_bf16 v24, v92, v12, v24
  v_dot2_f32_bf16 v25, v104, v12, v25
  v_dot2_f32_bf16 v24, v93, v13, v24
  v_dot2_f32_bf16 v25, v105, v13, v25
  v_dot2_f32_bf16 v24, v94, v14, v24
  v_dot2_f32_bf16 v25, v106, v14, v25
  v_dot2_f32_bf16 v24, v95, v15, v24
  v_dot2_f32_bf16 v25, v107, v15, v25
  v_dot2_f32_bf16 v24, v96, v16, v24
  v_dot2_f32_bf16 v25, v108, v16, v25
  v_dot2_f32_bf16 v24, v97, v17, v24
  v_dot2_f32_bf16 v25, v109, v17, v25
  v_dot2_f32_bf16 v24, v98, v18, v24
  v_dot2_f32_bf16 v25, v110, v18, v25
  v_dot2_f32_bf16 v24, v99, v19, v24
  v_dot2_f32_bf16 v25, v111, v19, v25
  buffer_load_dwordx4 v[88:91], v2, s[24:27], s61 offen offset:3072 nt
  buffer_load_dwordx4 v[92:95], v2, s[24:27], s61 offen offset:3200 nt
  buffer_load_dwordx4 v[96:99], v2, s[24:27], s61 offen offset:3328 nt
  s_mov_b64 exec, 1
  v_mov_b32 v3, 1
  v_mov_b32 v39, 0
  ds_add_u32 v39, v3 offset:16
  s_mov_b64 exec, -1
  v_add_f32_dpp v24, v24, v24 quad_perm:[1,0,3,2] row_mask:0xf bank_mask:0xf
  v_add_f32_dpp v25, v25, v25 quad_perm:[1,0,3,2] row_mask:0xf bank_mask:0xf
  s_nop 0
  v_add_f32_dpp v24, v24, v24 quad_perm:[2,3,0,1] row_mask:0xf bank_mask:0xf
  v_add_f32_dpp v25, v25, v25 quad_perm:[2,3,0,1] row_mask:0xf bank_mask:0xf
  s_nop 0
  v_add_f32_dpp v24, v24, v24 row_half_mirror row_mask:0xf bank_mask:0xf
  v_add_f32_dpp v25, v25, v25 row_half_mirror row_mask:0xf bank_mask:0xf
  v_cvt_pk_bf16_f32 v32, v24, v24
  v_cvt_pk_bf16_f32 v33, v25, v25
  v_and_b32 v32, 0xffff0000, v32
  v_and_b32 v33, 0xffff0000, v33
  v_mul_f32 v32, 0x3d93cd3a, v32
  v_mul_f32 v33, 0x3d93cd3a, v33
  v_cvt_pk_bf16_f32 v32, v32, v32
  v_cvt_pk_bf16_f32 v33, v33, v33
  v_and_b32 v32, 0xffff0000, v32
  v_and_b32 v33, 0xffff0000, v33
  v_mul_f32 v24, 0x3fb8aa3b, v32
  v_mul_f32 v25, 0x3fb8aa3b, v33
  v_max_f32 v32, v20, v21
  v_max_f32 v32, v32, v22
  v_max_f32 v32, v32, v23
  v_max_f32 v32, v32, v24
  v_max_f32 v32, v32, v25
  s_nop 1
  v_max_f32_dpp v32, v32, v32 row_ror:8 row_mask:0xf bank_mask:0xf
  s_nop 1
  v_max_f32_dpp v32, v32, v32 row_bcast:15 row_mask:0xa bank_mask:0xf
  s_nop 1
  v_max_f32_dpp v32, v32, v32 row_bcast:31 row_mask:0xc bank_mask:0xf
  s_nop 0
  v_readlane_b32 s66, v32, 63
  s_nop 1
  v_subrev_f32 v20, s66, v20
  v_subrev_f32 v21, s66, v21
  v_subrev_f32 v22, s66, v22
  v_subrev_f32 v23, s66, v23
  v_subrev_f32 v24, s66, v24
  v_subrev_f32 v25, s66, v25
  v_exp_f32 v20, v20
  v_exp_f32 v21, v21
  v_exp_f32 v22, v22
  v_exp_f32 v23, v23
  v_exp_f32 v24, v24
  v_exp_f32 v25, v25
  v_add_f32 v27, v20, v21
  v_add_f32 v27, v27, v22
  v_add_f32 v27, v27, v23
  v_add_f32 v27, v27, v24
  v_add_f32 v27, v27, v25
  v_cvt_pk_bf16_f32 v20, v20, v20
  v_cvt_pk_bf16_f32 v21, v21, v21
  v_cvt_pk_bf16_f32 v22, v22, v22
  v_cvt_pk_bf16_f32 v23, v23, v23
  v_cvt_pk_bf16_f32 v24, v24, v24
  v_cvt_pk_bf16_f32 v25, v25, v25
  v_and_b32 v28, v20, v4
  v_and_b32 v29, v20, v5
  v_and_b32 v30, v20, v6
  v_and_b32 v31, v20, v7
  s_waitcnt vmcnt(15)
  s_nop 0
  v_mfma_f32_16x16x32_bf16 v[8:11], v[112:115], v[28:31], 0
  v_mfma_f32_16x16x32_bf16 v[12:15], v[116:119], v[28:31], 0
  v_mfma_f32_16x16x32_bf16 v[16:19], v[120:123], v[28:31], 0
  v_and_b32 v32, v21, v4
  v_and_b32 v33, v21, v5
  v_and_b32 v34, v21, v6
  v_and_b32 v35, v21, v7
  s_waitcnt vmcnt(12)
  s_nop 0
  v_mfma_f32_16x16x32_bf16 v[8:11], v[40:43], v[32:35], v[8:11]
  v_mfma_f32_16x16x32_bf16 v[12:15], v[44:47], v[32:35], v[12:15]
  v_mfma_f32_16x16x32_bf16 v[16:19], v[48:51], v[32:35], v[16:19]
  v_and_b32 v28, v22, v4
  v_and_b32 v29, v22, v5
  v_and_b32 v30, v22, v6
  v_and_b32 v31, v22, v7
  s_waitcnt vmcnt(9)
  s_nop 0
  v_mfma_f32_16x16x32_bf16 v[8:11], v[52:55], v[28:31], v[8:11]
  v_mfma_f32_16x16x32_bf16 v[12:15], v[56:59], v[28:31], v[12:15]
  v_mfma_f32_16x16x32_bf16 v[16:19], v[60:63], v[28:31], v[16:19]
  v_and_b32 v32, v23, v4
  v_and_b32 v33, v23, v5
  v_and_b32 v34, v23, v6
  v_and_b32 v35, v23, v7
  s_waitcnt vmcnt(6)
  s_nop 0
  v_mfma_f32_16x16x32_bf16 v[8:11], v[64:67], v[32:35], v[8:11]
  v_mfma_f32_16x16x32_bf16 v[12:15], v[68:71], v[32:35], v[12:15]
  v_mfma_f32_16x16x32_bf16 v[16:19], v[72:75], v[32:35], v[16:19]
  v_and_b32 v28, v24, v4
  v_and_b32 v29, v24, v5
  v_and_b32 v30, v24, v6
  v_and_b32 v31, v24, v7
  s_waitcnt vmcnt(3)
  s_nop 0
  v_mfma_f32_16x16x32_bf16 v[8:11], v[76:79], v[28:31], v[8:11]
  v_mfma_f32_16x16x32_bf16 v[12:15], v[80:83], v[28:31], v[12:15]
  v_mfma_f32_16x16x32_bf16 v[16:19], v[84:87], v[28:31], v[16:19]
  v_and_b32 v32, v25, v4
  v_and_b32 v33, v25, v5
  v_and_b32 v34, v25, v6
  v_and_b32 v35, v25, v7
  s_waitcnt vmcnt(0)
  s_nop 0
  v_mfma_f32_16x16x32_bf16 v[8:11], v[88:91], v[32:35], v[8:11]
  v_mfma_f32_16x16x32_bf16 v[12:15], v[92:95], v[32:35], v[12:15]
  v_mfma_f32_16x16x32_bf16 v[16:19], v[96:99], v[32:35], v[16:19]
L_nowo:
  s_lshl_b32 s63, 1, s52
  s_and_b32 s63, s63, 3855
  s_cbranch_scc0 L_dyndone
  s_add_u32 s63, s51, 1179648
  s_add_u32 s36, s6, s63
  s_addc_u32 s37, s7, 0
  s_and_b32 s37, s37, 0xffff
  s_mov_b32 s38, 393216
  s_mov_b32 s39, 0x00020000
  s_add_u32 s40, s8, s63
  s_addc_u32 s41, s9, 0
  s_and_b32 s41, s41, 0xffff
  s_mov_b32 s42, 393216
  s_mov_b32 s43, 0x00020000
  s_lshl_b32 s50, s53, 8
  s_lshl_b32 s63, s55, 7
  s_add_u32 s50, s50, s63
  s_add_u32 s50, s50, 917504
  s_mul_i32 s63, s55, 384
  v_lshlrev_b32 v38, 4, v37
  v_add_u32 v38, s63, v38
  ds_read_b128 v[112:115], v38 offset:256
  ds_read_b128 v[116:119], v38 offset:384
  ds_read_b128 v[120:123], v38 offset:512
  v_mov_b32 v39, 0
  s_mov_b32 s64, 0
L_spl_5:
  ds_read_b32 v3, v39 offset:16
  s_waitcnt lgkmcnt(0)
  v_readfirstlane_b32 s65, v3
  s_nop 1
  s_cmp_ge_u32 s65, 16
  s_cbranch_scc1 L_spld_6
  s_add_u32 s64, s64, 1
  s_cmp_lt_u32 s64, 2097152
  s_sleep 1
  s_cbranch_scc1 L_spl_5
L_spld_6:
  v_mov_b32 v126, 0
  s_mov_b64 exec, 1
  v_mov_b32 v125, 1
  buffer_atomic_add v125, v126, s[28:31], s50 offen sc0 sc1
  s_mov_b64 exec, -1
  s_waitcnt vmcnt(0)
  v_readfirstlane_b32 s49, v125
L_dyn:
  s_nop 1
  s_cmp_ge_u32 s49, 64
  s_cbranch_scc1 L_dyndone
  s_mul_i32 s63, s49, 6144
  buffer_load_dwordx4 v[64:67], v2, s[36:39], s63 offen offset:0 nt
  buffer_load_dwordx4 v[68:71], v2, s[36:39], s63 offen offset:128 nt
  buffer_load_dwordx4 v[72:75], v2, s[36:39], s63 offen offset:256 nt
  buffer_load_dwordx4 v[76:79], v2, s[36:39], s63 offen offset:3072 nt
  buffer_load_dwordx4 v[80:83], v2, s[36:39], s63 offen offset:3200 nt
  buffer_load_dwordx4 v[84:87], v2, s[36:39], s63 offen offset:3328 nt
  buffer_load_dwordx4 v[88:91], v2, s[40:43], s63 offen offset:0 nt
  buffer_load_dwordx4 v[92:95], v2, s[40:43], s63 offen offset:128 nt
  buffer_load_dwordx4 v[96:99], v2, s[40:43], s63 offen offset:256 nt
  buffer_load_dwordx4 v[100:103], v2, s[40:43], s63 offen offset:3072 nt
  buffer_load_dwordx4 v[104:107], v2, s[40:43], s63 offen offset:3200 nt
  buffer_load_dwordx4 v[108:111], v2, s[40:43], s63 offen offset:3328 nt
  s_mov_b64 exec, 1
  v_mov_b32 v125, 1
  buffer_atomic_add v125, v126, s[28:31], s50 offen sc0 sc1
  s_mov_b64 exec, -1
  s_waitcnt vmcnt(7)
  v_dot2_f32_bf16 v20, v64, v112, 0
  v_dot2_f32_bf16 v21, v76, v112, 0
  v_dot2_f32_bf16 v20, v65, v113, v20
  v_dot2_f32_bf16 v21, v77, v113, v21
  v_dot2_f32_bf16 v20, v66, v114, v20
  v_dot2_f32_bf16 v21, v78, v114, v21
  v_dot2_f32_bf16 v20, v67, v115, v20
  v_dot2_f32_bf16 v21, v79, v115, v21
  v_dot2_f32_bf16 v20, v68, v116, v20
  v_dot2_f32_bf16 v21, v80, v116, v21
  v_dot2_f32_bf16 v20, v69, v117, v20
  v_dot2_f32_bf16 v21, v81, v117, v21
  v_dot2_f32_bf16 v20, v70, v118, v20
  v_dot2_f32_bf16 v21, v82, v118, v21
  v_dot2_f32_bf16 v20, v71, v119, v20
  v_dot2_f32_bf16 v21, v83, v119, v21
  v_dot2_f32_bf16 v20, v72, v120, v20
  v_dot2_f32_bf16 v21, v84, v120, v21
  v_dot2_f32_bf16 v20, v73, v121, v20
  v_dot2_f32_bf16 v21, v85, v121, v21
  v_dot2_f32_bf16 v20, v74, v122, v20
  v_dot2_f32_bf16 v21, v86, v122, v21
  v_dot2_f32_bf16 v20, v75, v123, v20
  v_dot2_f32_bf16 v21, v87, v123, v21
  s_nop 1
  v_add_f32_dpp v20, v20, v20 quad_perm:[1,0,3,2] row_mask:0xf bank_mask:0xf
  v_add_f32_dpp v21, v21, v21 quad_perm:[1,0,3,2] row_mask:0xf bank_mask:0xf
  s_nop 0
  v_add_f32_dpp v20, v20, v20 quad_perm:[2,3,0,1] row_mask:0xf bank_mask:0xf
  v_add_f32_dpp v21, v21, v21 quad_perm:[2,3,0,1] row_mask:0xf bank_mask:0xf
  s_nop 0
  v_add_f32_dpp v20, v20, v20 row_half_mirror row_mask:0xf bank_mask:0xf
  v_add_f32_dpp v21, v21, v21 row_half_mirror row_mask:0xf bank_mask:0xf
  v_cvt_pk_bf16_f32 v32, v20, v20
  v_cvt_pk_bf16_f32 v33, v21, v21
  v_and_b32 v32, 0xffff0000, v32
  v_and_b32 v33, 0xffff0000, v33
  v_mul_f32 v32, 0x3d93cd3a, v32
  v_mul_f32 v33, 0x3d93cd3a, v33
  v_cvt_pk_bf16_f32 v32, v32, v32
  v_cvt_pk_bf16_f32 v33, v33, v33
  v_and_b32 v32, 0xffff0000, v32
  v_and_b32 v33, 0xffff0000, v33
  v_mul_f32 v20, 0x3fb8aa3b, v32
  v_mul_f32 v21, 0x3fb8aa3b, v33
  v_max_f32 v32, v20, v21
  v_max_f32 v32, s66, v32
  s_nop 1
  v_max_f32_dpp v32, v32, v32 row_ror:8 row_mask:0xf bank_mask:0xf
  s_nop 1
  v_max_f32_dpp v32, v32, v32 row_bcast:15 row_mask:0xa bank_mask:0xf
  s_nop 1
  v_max_f32_dpp v32, v32, v32 row_bcast:31 row_mask:0xc bank_mask:0xf
  s_nop 0
  v_readlane_b32 s67, v32, 63
  v_mov_b32 v33, s66
  s_nop 0
  v_subrev_f32 v33, s67, v33
  v_subrev_f32 v20, s67, v20
  v_subrev_f32 v21, s67, v21
  v_exp_f32 v33, v33
  v_exp_f32 v20, v20
  v_exp_f32 v21, v21
  s_mov_b32 s66, s67
  v_mul_f32 v8, v33, v8
  v_mul_f32 v9, v33, v9
  v_mul_f32 v10, v33, v10
  v_mul_f32 v11, v33, v11
  v_mul_f32 v12, v33, v12
  v_mul_f32 v13, v33, v13
  v_mul_f32 v14, v33, v14
  v_mul_f32 v15, v33, v15
  v_mul_f32 v16, v33, v16
  v_mul_f32 v17, v33, v17
  v_mul_f32 v18, v33, v18
  v_mul_f32 v19, v33, v19
  v_fma_f32 v27, v27, v33, v20
  v_add_f32 v27, v27, v21
  v_cvt_pk_bf16_f32 v20, v20, v20
  v_cvt_pk_bf16_f32 v21, v21, v21
  v_and_b32 v28, v20, v4
  v_and_b32 v29, v20, v5
  v_and_b32 v30, v20, v6
  v_and_b32 v31, v20, v7
  v_and_b32 v32, v21, v4
  v_and_b32 v33, v21, v5
  v_and_b32 v34, v21, v6
  v_and_b32 v35, v21, v7
  s_waitcnt vmcnt(1)
  v_mfma_f32_16x16x32_bf16 v[8:11], v[88:91], v[28:31], v[8:11]
  v_mfma_f32_16x16x32_bf16 v[12:15], v[92:95], v[28:31], v[12:15]
  v_mfma_f32_16x16x32_bf16 v[16:19], v[96:99], v[28:31], v[16:19]
  v_mfma_f32_16x16x32_bf16 v[8:11], v[100:103], v[32:35], v[8:11]
  v_mfma_f32_16x16x32_bf16 v[12:15], v[104:107], v[32:35], v[12:15]
  v_mfma_f32_16x16x32_bf16 v[16:19], v[108:111], v[32:35], v[16:19]
  s_waitcnt vmcnt(0)
  v_readfirstlane_b32 s49, v125
  s_nop 7
  s_branch L_dyn
L_dyndone:
  v_add_f32_dpp v27, v27, v27 row_ror:8 row_mask:0xf bank_mask:0xf
  s_nop 1
  v_add_f32_dpp v27, v27, v27 row_bcast:15 row_mask:0xa bank_mask:0xf
  s_nop 1
  v_add_f32_dpp v27, v27, v27 row_bcast:31 row_mask:0xc bank_mask:0xf
  s_nop 0
  v_readlane_b32 s67, v27, 63
  v_lshrrev_b32 v38, 5, v1
  v_mul_u32_u24 v38, 768, v38
  v_bfe_u32 v39, v1, 4, 1
  v_lshl_add_u32 v38, v39, 7, v38
  v_lshl_add_u32 v38, v37, 2, v38
  s_mul_i32 s63, s52, 1536
  s_add_u32 s63, s63, 8704
  v_add_u32 v38, s63, v38
  s_lshl_b32 s63, s52, 3
  v_mov_b32 v39, s63
  v_mov_b32 v34, s66
  v_mov_b32 v35, s67
  s_mov_b64 exec, s[58:59]
  ds_write2_b32 v38, v8, v9 offset0:0 offset1:8
  ds_write2_b32 v38, v10, v11 offset0:16 offset1:24
  ds_write2_b32 v38, v12, v13 offset0:64 offset1:72
  ds_write2_b32 v38, v14, v15 offset0:80 offset1:88
  ds_write2_b32 v38, v16, v17 offset0:128 offset1:136
  ds_write2_b32 v38, v18, v19 offset0:144 offset1:152
  s_mov_b64 exec, 1
  ds_write_b64 v39, v[34:35] offset:7168
  s_mov_b64 exec, -1
  s_sub_u32 s63, s52, 8
  s_lshr_b32 s63, s63, 2
  s_and_b32 s63, s63, 1
  s_lshl_b32 s64, s63, 6
  v_mov_b32 v102, s64
  v_bfe_u32 v39, v0, 5, 3
  v_mul_u32_u24 v39, 24, v39
  v_and_b32 v3, 31, v0
  v_add_u32 v39, v39, v3
  v_lshlrev_b32 v39, 2, v39
  s_mul_i32 s64, s63, 12288
  v_add_u32 v103, s64, v39
  v_and_b32 v100, 3, v0
  v_lshlrev_b32 v100, 3, v100
  v_mov_b32 v101, s68
  v_lshrrev_b32 v100, v100, v101
  v_lshlrev_b32 v104, 2, v0
  v_cmp_eq_u32 s[40:41], 24, v3
  v_cmp_eq_u32 s[42:43], 25, v3
  s_waitcnt lgkmcnt(0)
  s_barrier
  s_cmp_lt_u32 s52, 5
  s_cbranch_scc1 L_oproj
  s_cmp_eq_u32 s52, 5
  s_cbranch_scc1 L_hop1
  s_cmp_lt_u32 s52, 8
  s_cbranch_scc1 L_exit
  ds_read_b128 v[64:67], v102 offset:7168
  ds_read_b128 v[68:71], v102 offset:7184
  ds_read_b128 v[72:75], v102 offset:7200
  ds_read_b128 v[76:79], v102 offset:7216
  ds_read2st64_b32 v[80:81], v103 offset0:34 offset1:37
  ds_read2st64_b32 v[82:83], v103 offset0:40 offset1:43
  ds_read2st64_b32 v[84:85], v103 offset0:46 offset1:49
  ds_read2st64_b32 v[86:87], v103 offset0:52 offset1:55
  ds_read2st64_b32 v[88:89], v103 offset0:58 offset1:61
  ds_read2st64_b32 v[90:91], v103 offset0:64 offset1:67
  ds_read2st64_b32 v[92:93], v103 offset0:70 offset1:73
  ds_read2st64_b32 v[94:95], v103 offset0:76 offset1:79
  s_lshl_b32 s63, s2, 11
  s_add_u32 s63, s63, 1046528
  s_waitcnt lgkmcnt(8)
  v_max3_f32 v96, v64, v66, v68
  v_max3_f32 v97, v70, v72, v74
  v_max3_f32 v96, v96, v76, v78
  v_max_f32 v96, v96, v97
  v_and_b32 v96, 0xffffff00, v96
  v_sub_f32 v64, v64, v96
  v_sub_f32 v66, v66, v96
  v_sub_f32 v68, v68, v96
  v_sub_f32 v70, v70, v96
  v_sub_f32 v72, v72, v96
  v_sub_f32 v74, v74, v96
  v_sub_f32 v76, v76, v96
  v_sub_f32 v78, v78, v96
  v_exp_f32 v64, v64
  v_exp_f32 v66, v66
  v_exp_f32 v68, v68
  v_exp_f32 v70, v70
  v_exp_f32 v72, v72
  v_exp_f32 v74, v74
  v_exp_f32 v76, v76
  v_exp_f32 v78, v78
  v_mul_f32 v97, v64, v65
  v_mul_f32 v99, v66, v67
  v_fmac_f32 v97, v68, v69
  v_fmac_f32 v99, v70, v71
  v_fmac_f32 v97, v72, v73
  v_fmac_f32 v99, v74, v75
  v_fmac_f32 v97, v76, v77
  v_fmac_f32 v99, v78, v79
  v_add_f32 v97, v97, v99
  s_waitcnt lgkmcnt(0)
  v_add_f32 v80, v80, v81
  v_add_f32 v82, v82, v83
  v_add_f32 v84, v84, v85
  v_add_f32 v86, v86, v87
  v_add_f32 v88, v88, v89
  v_add_f32 v90, v90, v91
  v_add_f32 v92, v92, v93
  v_add_f32 v94, v94, v95
  v_mul_f32 v98, v64, v80
  v_mul_f32 v99, v66, v82
  v_fmac_f32 v98, v68, v84
  v_fmac_f32 v99, v70, v86
  v_fmac_f32 v98, v72, v88
  v_fmac_f32 v99, v74, v90
  v_fmac_f32 v98, v76, v92
  v_fmac_f32 v99, v78, v94
  v_add_f32 v98, v98, v99
  v_cndmask_b32 v98, v98, v96, s[40:41]
  v_cndmask_b32 v98, v98, v97, s[42:43]
  v_bfi_b32 v98, v36, v100, v98
  buffer_store_dword v98, v104, s[28:31], s63 offen sc1
  s_mov_b64 exec, 1
  v_mov_b32 v3, 1
  v_mov_b32 v39, 0
  ds_add_u32 v39, v3 offset:32
  s_mov_b64 exec, -1
  s_branch L_reducer
L_hop1:
  v_lshrrev_b32 v38, 4, v1
  v_lshlrev_b32 v38, 11, v38
  v_bfe_u32 v39, v1, 3, 1
  v_lshl_add_u32 v38, v39, 10, v38
  v_lshl_add_u32 v38, v37, 4, v38
  s_lshl_b32 s63, s53, 14
  s_lshl_b32 s64, s54, 7
  s_add_u32 s63, s63, s64
  s_add_u32 s63, s63, 1048576
  s_add_u32 s67, s63, 8192
  s_mov_b32 s64, 0
  buffer_load_dwordx4 v[64:67], v38, s[28:31], s63 offen sc1
  buffer_load_dwordx4 v[68:71], v38, s[28:31], s67 offen sc1
L_h1poll:
  s_waitcnt vmcnt(0)
  v_perm_b32 v73, v65, v64, s72
  v_perm_b32 v74, v67, v66, s73
  v_or_b32 v73, v73, v74
  v_xor_b32 v72, s68, v73
  v_perm_b32 v73, v69, v68, s72
  v_perm_b32 v74, v71, v70, s73
  v_or_b32 v73, v73, v74
  v_xor_b32 v73, s68, v73
  v_or_b32 v72, v72, v73
  v_cmp_ne_u32 vcc, 0, v72
  s_nop 1
  s_cbranch_vccz L_h1ok0
  buffer_load_dwordx4 v[64:67], v38, s[28:31], s63 offen sc1
  buffer_load_dwordx4 v[68:71], v38, s[28:31], s67 offen sc1
  s_add_u32 s64, s64, 1
  s_cmp_lt_u32 s64, 65536
  s_cbranch_scc1 L_h1poll
L_h1ok0:
  v_and_b32 v92, 0xffffff00, v64
  v_and_b32 v93, 0xffffff00, v65
  v_and_b32 v94, 0xffffff00, v66
  v_and_b32 v95, 0xffffff00, v67
  v_and_b32 v96, 0xffffff00, v68
  v_and_b32 v97, 0xffffff00, v69
  v_and_b32 v98, 0xffffff00, v70
  v_and_b32 v99, 0xffffff00, v71
L_h1done:
  ds_swizzle_b32 v72, v92 offset:216
  ds_swizzle_b32 v73, v93 offset:216
  ds_swizzle_b32 v74, v96 offset:216
  ds_swizzle_b32 v75, v97 offset:216
  s_waitcnt lgkmcnt(0)
  v_max_f32 v76, v72, v74
  v_mov_b32 v77, v76
  v_mov_b32 v78, v76
  s_nop 1
  v_permlane32_swap_b32 v77, v78
  v_max_f32 v76, v77, v78
  v_mov_b32 v77, v76
  v_mov_b32 v78, v76
  s_nop 1
  v_permlane16_swap_b32 v77, v78
  v_max_f32 v76, v77, v78
  v_sub_f32 v72, v72, v76
  v_sub_f32 v74, v74, v76
  v_exp_f32 v72, v72
  v_exp_f32 v74, v74
  v_mul_f32 v79, v72, v73
  v_fmac_f32 v79, v74, v75
  v_mul_f32 v92, v72, v92
  v_mul_f32 v93, v72, v93
  v_mul_f32 v94, v72, v94
  v_mul_f32 v95, v72, v95
  v_fmac_f32 v92, v74, v96
  v_fmac_f32 v93, v74, v97
  v_fmac_f32 v94, v74, v98
  v_fmac_f32 v95, v74, v99
  v_mov_b32 v77, v79
  v_mov_b32 v78, v79
  s_nop 1
  v_permlane32_swap_b32 v77, v78
  v_add_f32 v79, v77, v78
  v_mov_b32 v77, v79
  v_mov_b32 v78, v79
  s_nop 1
  v_permlane16_swap_b32 v77, v78
  v_add_f32 v79, v77, v78
  v_rcp_f32 v79, v79
  v_permlane32_swap_b32 v92, v94
  v_permlane32_swap_b32 v93, v95
  v_add_f32 v92, v92, v94
  v_add_f32 v93, v93, v95
  s_nop 1
  v_permlane16_swap_b32 v92, v93
  v_add_f32 v92, v92, v93
  v_mul_f32 v92, v92, v79
  v_cvt_pk_bf16_f32 v92, v92, v92
  v_bfe_u32 v39, v1, 3, 1
  v_mul_u32_u24 v39, 24, v39
  v_lshl_add_u32 v39, v37, 2, v39
  v_lshrrev_b32 v38, 4, v1
  v_add_u32 v39, v39, v38
  v_lshlrev_b32 v39, 2, v39
  v_cmp_gt_u32 vcc, 6, v37
  s_nop 1
  s_and_saveexec_b64 s[64:65], vcc
  ds_write_b32 v39, v92 offset:128
  s_mov_b64 exec, 1
  v_mov_b32 v3, 1
  v_mov_b32 v39, 0
  s_waitcnt lgkmcnt(0)
  ds_write_b32 v39, v3 offset:20
  s_mov_b64 exec, -1
  s_branch L_exit
L_oproj:
  v_mov_b32 v39, 0
  s_mov_b32 s64, 0
L_spl_7:
  ds_read_b32 v3, v39 offset:32
  s_waitcnt lgkmcnt(0)
  v_readfirstlane_b32 s65, v3
  s_nop 1
  s_cmp_ge_u32 s65, 8
  s_cbranch_scc1 L_spld_8
  s_add_u32 s64, s64, 1
  s_cmp_lt_u32 s64, 2097152
  s_sleep 0
  s_cbranch_scc1 L_spl_7
L_spld_8:
  s_mul_i32 s63, s53, 192
  s_mul_i32 s64, s54, 24
  s_add_u32 s63, s63, s64
  s_mul_i32 s63, s63, 1280
  s_add_u32 s44, s12, s63
  s_addc_u32 s45, s13, 0
  s_and_b32 s45, s45, 0xffff
  s_mov_b32 s46, 30720
  s_mov_b32 s47, 0x00020000
  v_lshrrev_b32 v38, 4, v1
  v_mul_u32_u24 v38, 1280, v38
  v_and_b32 v39, 15, v1
  v_lshl_add_u32 v38, v39, 4, v38
  s_lshl_b32 s63, s52, 8
  buffer_load_dwordx4 v[40:43], v38, s[44:47], s63 offen nt
  s_add_u32 s63, s63, 5120
  buffer_load_dwordx4 v[44:47], v38, s[44:47], s63 offen nt
  s_add_u32 s63, s63, 5120
  buffer_load_dwordx4 v[48:51], v38, s[44:47], s63 offen nt
  s_add_u32 s63, s63, 5120
  buffer_load_dwordx4 v[52:55], v38, s[44:47], s63 offen nt
  s_add_u32 s63, s63, 5120
  buffer_load_dwordx4 v[56:59], v38, s[44:47], s63 offen nt
  s_add_u32 s63, s63, 5120
  buffer_load_dwordx4 v[60:63], v38, s[44:47], s63 offen nt
  v_bfe_u32 v39, v1, 3, 1
  v_mul_u32_u24 v39, 24, v39
  v_lshrrev_b32 v38, 4, v1
  v_add_u32 v39, v39, v38
  v_lshlrev_b32 v38, 2, v39
  v_mov_b32 v39, 0
  s_mov_b32 s64, 0
L_spl_9:
  ds_read_b32 v3, v39 offset:20
  s_waitcnt lgkmcnt(0)
  v_readfirstlane_b32 s65, v3
  s_nop 1
  s_cmp_ge_u32 s65, 1
  s_cbranch_scc1 L_spld_10
  s_add_u32 s64, s64, 1
  s_cmp_lt_u32 s64, 2097152
  s_sleep 0
  s_cbranch_scc1 L_spl_9
L_spld_10:
  ds_read_b32 v80, v38 offset:128
  ds_read_b32 v81, v38 offset:144
  ds_read_b32 v82, v38 offset:160
  ds_read_b32 v83, v38 offset:176
  ds_read_b32 v84, v38 offset:192
  ds_read_b32 v85, v38 offset:208
  s_waitcnt vmcnt(0) lgkmcnt(0)
  v_and_b32 v28, v80, v4
  v_and_b32 v29, v80, v5
  v_and_b32 v30, v80, v6
  v_and_b32 v31, v80, v7
  s_nop 1
  v_mfma_f32_16x16x32_bf16 v[88:91], v[40:43], v[28:31], 0
  v_and_b32 v32, v81, v4
  v_and_b32 v33, v81, v5
  v_and_b32 v34, v81, v6
  v_and_b32 v35, v81, v7
  s_nop 1
  v_mfma_f32_16x16x32_bf16 v[88:91], v[44:47], v[32:35], v[88:91]
  v_and_b32 v28, v82, v4
  v_and_b32 v29, v82, v5
  v_and_b32 v30, v82, v6
  v_and_b32 v31, v82, v7
  s_nop 1
  v_mfma_f32_16x16x32_bf16 v[88:91], v[48:51], v[28:31], v[88:91]
  v_and_b32 v32, v83, v4
  v_and_b32 v33, v83, v5
  v_and_b32 v34, v83, v6
  v_and_b32 v35, v83, v7
  s_nop 1
  v_mfma_f32_16x16x32_bf16 v[88:91], v[52:55], v[32:35], v[88:91]
  v_and_b32 v28, v84, v4
  v_and_b32 v29, v84, v5
  v_and_b32 v30, v84, v6
  v_and_b32 v31, v84, v7
  s_nop 1
  v_mfma_f32_16x16x32_bf16 v[88:91], v[56:59], v[28:31], v[88:91]
  v_and_b32 v32, v85, v4
  v_and_b32 v33, v85, v5
  v_and_b32 v34, v85, v6
  v_and_b32 v35, v85, v7
  s_nop 1
  v_mfma_f32_16x16x32_bf16 v[88:91], v[60:63], v[32:35], v[88:91]
  v_bfe_u32 v39, v1, 3, 1
  v_mul_u32_u24 v39, 20, v39
  v_lshrrev_b32 v38, 4, v1
  v_add_u32 v38, v38, v39
  v_lshlrev_b32 v38, 15, v38
  v_lshl_add_u32 v38, v37, 4, v38
  s_lshl_b32 s63, s52, 17
  s_lshl_b32 s64, s2, 7
  s_add_u32 s63, s63, s64
  s_add_u32 s63, s63, 2097152
  v_bfi_b32 v88, v36, s68, v88
  v_bfi_b32 v89, v36, s69, v89
  v_bfi_b32 v90, v36, s70, v90
  v_bfi_b32 v91, v36, s71, v91
  buffer_store_dwordx4 v[88:91], v38, s[28:31], s63 offen sc1
  s_mov_b64 exec, 1
  v_mov_b32 v3, 1
  v_mov_b32 v39, 0
  ds_add_u32 v39, v3 offset:24
  s_mov_b64 exec, -1
  s_branch L_exit
L_reducer:
  s_cmp_lt_u32 s2, 216
  s_cbranch_scc1 L_exit
  s_cmp_ge_u32 s2, 256
  s_cbranch_scc1 L_exit
  s_sub_u32 s63, s2, 216
  s_lshl_b32 s66, s63, 15
  s_sub_u32 s67, s52, 8
  s_lshl_b32 s65, s67, 12
  s_add_u32 s66, s66, s65
  s_add_u32 s66, s66, 2097152
  v_lshlrev_b32 v38, 4, v1
  v_mov_b32 v39, 0
  s_mov_b32 s64, 0
L_spl_11:
  ds_read_b32 v3, v39 offset:24
  s_waitcnt lgkmcnt(0)
  v_readfirstlane_b32 s65, v3
  s_nop 1
  s_cmp_ge_u32 s65, 1
  s_cbranch_scc1 L_spld_12
  s_add_u32 s64, s64, 1
  s_cmp_lt_u32 s64, 2097152
  s_sleep 1
  s_cbranch_scc1 L_spl_11
L_spld_12:
  s_mov_b32 s64, 0
  buffer_load_dwordx4 v[64:67], v38, s[28:31], s66 offen offset:0 sc1
  buffer_load_dwordx4 v[68:71], v38, s[28:31], s66 offen offset:1024 sc1
  buffer_load_dwordx4 v[72:75], v38, s[28:31], s66 offen offset:2048 sc1
  buffer_load_dwordx4 v[76:79], v38, s[28:31], s66 offen offset:3072 sc1
L_h2poll:
  s_waitcnt vmcnt(0)
  v_perm_b32 v81, v65, v64, s72
  v_perm_b32 v82, v67, v66, s73
  v_or_b32 v81, v81, v82
  v_xor_b32 v80, s68, v81
  v_perm_b32 v81, v69, v68, s72
  v_perm_b32 v82, v71, v70, s73
  v_or_b32 v81, v81, v82
  v_xor_b32 v81, s68, v81
  v_or_b32 v80, v80, v81
  v_perm_b32 v81, v73, v72, s72
  v_perm_b32 v82, v75, v74, s73
  v_or_b32 v81, v81, v82
  v_xor_b32 v81, s68, v81
  v_or_b32 v80, v80, v81
  v_perm_b32 v81, v77, v76, s72
  v_perm_b32 v82, v79, v78, s73
  v_or_b32 v81, v81, v82
  v_xor_b32 v81, s68, v81
  v_or_b32 v80, v80, v81
  v_cmp_ne_u32 vcc, 0, v80
  s_nop 1
  s_cbranch_vccz L_h2ok0
  buffer_load_dwordx4 v[64:67], v38, s[28:31], s66 offen offset:0 sc1
  buffer_load_dwordx4 v[68:71], v38, s[28:31], s66 offen offset:1024 sc1
  buffer_load_dwordx4 v[72:75], v38, s[28:31], s66 offen offset:2048 sc1
  buffer_load_dwordx4 v[76:79], v38, s[28:31], s66 offen offset:3072 sc1
  s_add_u32 s64, s64, 1
  s_cmp_lt_u32 s64, 65536
  s_cbranch_scc1 L_h2poll
L_h2ok0:
  v_and_b32 v40, 0xffffff00, v64
  v_and_b32 v41, 0xffffff00, v65
  v_and_b32 v42, 0xffffff00, v66
  v_and_b32 v43, 0xffffff00, v67
  v_and_b32 v44, 0xffffff00, v68
  v_and_b32 v45, 0xffffff00, v69
  v_and_b32 v46, 0xffffff00, v70
  v_and_b32 v47, 0xffffff00, v71
  v_and_b32 v48, 0xffffff00, v72
  v_and_b32 v49, 0xffffff00, v73
  v_and_b32 v50, 0xffffff00, v74
  v_and_b32 v51, 0xffffff00, v75
  v_and_b32 v52, 0xffffff00, v76
  v_and_b32 v53, 0xffffff00, v77
  v_and_b32 v54, 0xffffff00, v78
  v_and_b32 v55, 0xffffff00, v79
L_h2done:
  v_add_f32 v40, v40, v44
  v_add_f32 v48, v48, v52
  v_add_f32 v41, v41, v45
  v_add_f32 v49, v49, v53
  v_add_f32 v42, v42, v46
  v_add_f32 v50, v50, v54
  v_add_f32 v43, v43, v47
  v_add_f32 v51, v51, v55
  v_add_f32 v40, v40, v48
  v_add_f32 v41, v41, v49
  v_add_f32 v42, v42, v50
  v_add_f32 v43, v43, v51
  v_add_f32_dpp v40, v40, v40 row_ror:8 row_mask:0xf bank_mask:0xf
  v_add_f32_dpp v41, v41, v41 row_ror:8 row_mask:0xf bank_mask:0xf
  v_add_f32_dpp v42, v42, v42 row_ror:8 row_mask:0xf bank_mask:0xf
  v_add_f32_dpp v43, v43, v43 row_ror:8 row_mask:0xf bank_mask:0xf
  s_nop 0
  v_permlane32_swap_b32 v40, v42
  v_permlane32_swap_b32 v41, v43
  v_add_f32 v40, v40, v42
  v_add_f32 v41, v41, v43
  s_nop 1
  v_permlane16_swap_b32 v40, v41
  v_add_f32 v40, v40, v41
  v_lshrrev_b32 v38, 4, v1
  v_lshl_add_u32 v38, v37, 2, v38
  v_lshlrev_b32 v38, 2, v38
  s_lshl_b32 s65, s67, 7
  v_add_u32 v38, s65, v38
  ds_write_b32 v38, v40 offset:7424
  s_waitcnt lgkmcnt(0)
  s_barrier
  s_cmp_lg_u32 s52, 8
  s_cbranch_scc1 L_exit
  v_lshlrev_b32 v38, 2, v1
  ds_read_b32 v56, v38 offset:7424
  ds_read_b32 v57, v38 offset:7552
  ds_read_b32 v58, v38 offset:7680
  ds_read_b32 v59, v38 offset:7808
  ds_read_b32 v60, v38 offset:7936
  ds_read_b32 v61, v38 offset:8064
  ds_read_b32 v62, v38 offset:8192
  ds_read_b32 v63, v38 offset:8320
  s_mov_b32 s48, s14
  s_and_b32 s49, s15, 0xffff
  s_mov_b32 s50, 2560
  s_mov_b32 s51, 0x00020000
  v_and_b32 v39, 3, v1
  v_lshlrev_b32 v39, 3, v39
  v_lshrrev_b32 v3, 2, v1
  v_add_u32 v39, v39, v3
  v_lshlrev_b32 v39, 1, v39
  s_lshl_b32 s65, s63, 6
  s_waitcnt lgkmcnt(0)
  v_add_f32 v56, v56, v57
  v_add_f32 v58, v58, v59
  v_add_f32 v60, v60, v61
  v_add_f32 v62, v62, v63
  v_add_f32 v56, v56, v58
  v_add_f32 v60, v60, v62
  v_add_f32 v56, v56, v60
  v_cvt_pk_bf16_f32 v56, v56, v56
  s_mov_b32 exec_lo, -1
  s_mov_b32 exec_hi, 0
  buffer_store_short v56, v39, s[48:51], s65 offen
  s_cmp_lg_u32 s63, 0
  s_cbranch_scc1 L_noep
  s_mov_b64 exec, 1
  v_mov_b32 v3, s33
  v_mov_b32 v39, 983040
  buffer_store_dword v3, v39, s[28:31], 0 offen
L_noep:
L_exit:
L_end:
  s_endpgm
.section .rodata,"a"
.p2align 6
.amdhsa_kernel standalone__sliding_block_cached__decode_kernel
  .amdhsa_next_free_vgpr 128
  .amdhsa_next_free_sgpr 102
  .amdhsa_accum_offset 128
  .amdhsa_group_segment_fixed_size 0
  .amdhsa_kernarg_size 64
  .amdhsa_user_sgpr_count 2
  .amdhsa_user_sgpr_kernarg_segment_ptr 1
  .amdhsa_system_sgpr_workgroup_id_x 1
.end_amdhsa_kernel
```
